```python
import torch

def _softmax(x, axis=-1):
    return torch.softmax(x, dim=axis)
def _gelu(x):
    return torch.nn.functional.gelu(x, approximate="tanh")
def _silu(x):
    return torch.nn.functional.silu(x)
def _sigmoid(x):
    return torch.sigmoid(x)
def _layernorm(x, axis=-1, eps=1e-5):
    m = x.mean(dim=axis, keepdim=True)
    v = x.var(dim=axis, keepdim=True, unbiased=False)
    return (x - m) / torch.sqrt(v + eps)
def _scatter_add(tgt, idx, src, axis=0):
    return tgt.clone().index_add_(axis, idx, src)
def _segment_sum(src, seg, n):
    out = torch.zeros((n,) + src.shape[1:], dtype=src.dtype)
    return out.index_add_(0, seg, src)
def _pad(x, pw):
    flat = tuple(v for pair in reversed(pw) for v in pair)
    return torch.nn.functional.pad(x, flat)

kernel_name = 'concat_heads__gqa_block_cached__sliding_block_cached__decode'

def setup_inputs():

    _w = (lambda a: (lambda t: t.to(torch.bfloat16) if t.is_floating_point() else t)(torch.as_tensor(a)))
    def _A_setup():
        B, Sq, D = 2, 1, 512
        Hq, Hkv, Sk, Dh = 32, 8, 32768, 128
        assert Hq % Hkv == 0, (Hq, Hkv)
        return {
            "x": _w((lambda *s: torch.randn(*s, dtype=torch.bfloat16) * 1.6)(B, Sq, D)),
            "k_cache": _w((lambda *s: torch.randn(*s, dtype=torch.bfloat16) * 1.6)(B, Hkv, Sk, Dh)),
            "v_cache": _w((lambda *s: torch.randn(*s, dtype=torch.bfloat16) * 0.05)(B, Hkv, Sk, Dh)),
            "wq": _w((lambda *s: torch.randn(*s, dtype=torch.bfloat16) * 1.6)(D, Hq * Dh) * (D ** -0.5)),
            "wo": _w((lambda *s: torch.randn(*s, dtype=torch.bfloat16) * 0.05)(Hq * Dh, D) * ((Hq * Dh) ** -0.5)),
        }
    _A_in = _A_setup()

    def _B_setup():
        B, Sq, D = 2, 1, 512
        Hq, Hkv, Sk, Dh = 32, 8, 32768, 128
        assert Hq % Hkv == 0, (Hq, Hkv)
        return {
            "x": _w((lambda *s: torch.randn(*s, dtype=torch.bfloat16) * 1.6)(B, Sq, D)),
            "k_cache": _w((lambda *s: torch.randn(*s, dtype=torch.bfloat16) * 1.6)(B, Hkv, Sk, Dh)),
            "v_cache": _w((lambda *s: torch.randn(*s, dtype=torch.bfloat16) * 0.05)(B, Hkv, Sk, Dh)),
            "wq": _w((lambda *s: torch.randn(*s, dtype=torch.bfloat16) * 1.6)(D, Hq * Dh) * (D ** -0.5)),
            "wo": _w((lambda *s: torch.randn(*s, dtype=torch.bfloat16) * 0.05)(Hq * Dh, D) * ((Hq * Dh) ** -0.5)),
        }
    _B_in = _B_setup()

    return {
        "A_x": _A_in["x"],
        "A_k_cache": _A_in["k_cache"],
        "A_v_cache": _A_in["v_cache"],
        "A_wq": _A_in["wq"],
        "A_wo": _A_in["wo"],
        "B_x": _B_in["x"],
        "B_k_cache": _B_in["k_cache"],
        "B_v_cache": _B_in["v_cache"],
        "B_wq": _B_in["wq"],
        "B_wo": _B_in["wo"],
    }

def reference(A_x, A_k_cache, A_v_cache, A_wq, A_wo, B_x, B_k_cache, B_v_cache, B_wq, B_wo):
    def _A_ref(x, k_cache, v_cache, wq, wo):
        B, Sq, D = x.shape
        Hq, Dh = 32, 128
        Hkv = k_cache.shape[1]
        rep = Hq // Hkv
        q = (lambda x, *d: x.permute(*d))((x @ wq).reshape(B, Sq, Hq, Dh), 0, 2, 1, 3)
        k = (lambda x, n, axis: torch.repeat_interleave(x, n, dim=axis))(k_cache, rep, axis=1)
        v = (lambda x, n, axis: torch.repeat_interleave(x, n, dim=axis))(v_cache, rep, axis=1)
        scores = torch.einsum("bhqd,bhkd->bhqk", q, k) * (Dh ** -0.5)
        p = _softmax(scores, axis=-1)
        o = torch.einsum("bhqk,bhkd->bhqd", p, v)
        return (lambda x, *d: x.permute(*d))(o, 0, 2, 1, 3).reshape(B, Sq, Hq * Dh) @ wo

    def _B_ref(x, k_cache, v_cache, wq, wo):
        B, Sq, D = x.shape
        Hq, Dh = 32, 128
        Hkv, Sk = k_cache.shape[1], k_cache.shape[2]
        W = min(4096, max(256, Sk // 4))
        rep = Hq // Hkv
        q = (lambda x, *d: x.permute(*d))((x @ wq).reshape(B, Sq, Hq, Dh), 0, 2, 1, 3)
        k = (lambda x, n, axis: torch.repeat_interleave(x, n, dim=axis))(k_cache[:, :, Sk - W:, :], rep, axis=1)
        v = (lambda x, n, axis: torch.repeat_interleave(x, n, dim=axis))(v_cache[:, :, Sk - W:, :], rep, axis=1)
        scores = torch.einsum("bhqd,bhkd->bhqk", q, k) * (Dh ** -0.5)
        p = _softmax(scores, axis=-1)
        o = torch.einsum("bhqk,bhkd->bhqd", p, v)
        return (lambda x, *d: x.permute(*d))(o, 0, 2, 1, 3).reshape(B, Sq, Hq * Dh) @ wo

    a = _A_ref(A_x, A_k_cache, A_v_cache, A_wq, A_wo)
    b = _B_ref(B_x, B_k_cache, B_v_cache, B_wq, B_wo)
    return torch.concatenate([a, b], axis=-1)
```

```asm
; @launch grid=(256,1,1) block=(256,1,1) lds=55296
.amdgcn_target "amdgcn-amd-amdhsa--gfx950"
.text
.globl concat_heads__gqa_block_cached__sliding_block_cached__decode_kernel
.p2align 8
.type concat_heads__gqa_block_cached__sliding_block_cached__decode_kernel,@function
concat_heads__gqa_block_cached__sliding_block_cached__decode_kernel:
    s_cmp_ge_u32 s2, 256
    s_cbranch_scc1 L_end
    s_load_dwordx16 s[4:19], s[0:1], 0
    s_load_dwordx8 s[20:27], s[0:1], 64
    s_load_dwordx2 s[28:29], s[0:1], 96
    v_lshrrev_b32 v4, 6, v0
    v_and_b32 v1, 63, v0
    v_readfirstlane_b32 s3, v4
    v_lshrrev_b32 v4, 4, v1
    v_and_b32 v5, 15, v1
    v_lshlrev_b32 v2, 8, v5
    v_lshl_add_u32 v2, v4, 4, v2
    v_lshlrev_b32 v3, 4, v5
    v_lshl_add_u32 v3, v4, 10, v3
    v_lshrrev_b32 v6, 2, v1
    v_lshlrev_b32 v6, 13, v6
    v_and_b32 v7, 3, v1
    v_lshl_add_u32 v6, v7, 4, v6
    v_and_b32 v7, 1, v1
    v_lshlrev_b32 v7, 10, v7
    v_lshl_add_u32 v7, v4, 4, v7
    s_lshr_b32 s58, s2, 4
    s_add_u32 s63, s2, s58
    s_and_b32 s63, s63, 15
    s_lshr_b32 s56, s63, 3
    s_and_b32 s57, s63, 7
    s_and_b32 s96, s2, 7
    s_lshr_b32 s97, s2, 7
    s_bfe_u32 s98, s2, 0x40003
    s_lshl_b32 s68, s63, 23
    s_add_u32 s72, s68, 7340032
    s_mov_b32 s69, s68
    s_lshl_b32 s62, s3, 20
    s_lshl_b32 s73, s96, 10
    s_add_u32 s62, s62, s73
    s_lshl_b32 s73, s98, 6
    s_add_u32 s62, s62, s73
    s_lshl_b32 s75, s3, 13
    s_lshl_b32 s73, s3, 8
    s_lshl_b32 s60, s3, 12
    s_mov_b32 s46, 0x400000
    s_mov_b32 s47, 0x20000
    s_mov_b32 s50, 0x800
    s_mov_b32 s51, 0x20000
    s_waitcnt lgkmcnt(0)
    s_cmp_eq_u32 s97, 0
    s_cselect_b32 s44, s10, s20
    s_cselect_b32 s45, s11, s21
    s_cselect_b32 s48, s4, s14
    s_cselect_b32 s49, s5, s15
    s_add_u32 m0, s75, 0
    s_nop 0
    buffer_load_dwordx4 v6, s[44:47], s62 offen nt lds
    s_add_u32 m0, s75, 1024
    s_add_u32 s62, s62, 0x20000
    buffer_load_dwordx4 v6, s[44:47], s62 offen nt lds
    s_add_u32 m0, s75, 2048
    s_add_u32 s62, s62, 0x20000
    buffer_load_dwordx4 v6, s[44:47], s62 offen nt lds
    s_add_u32 m0, s75, 3072
    s_add_u32 s62, s62, 0x20000
    buffer_load_dwordx4 v6, s[44:47], s62 offen nt lds
    s_add_u32 m0, s75, 4096
    s_add_u32 s62, s62, 0x20000
    buffer_load_dwordx4 v6, s[44:47], s62 offen nt lds
    s_add_u32 m0, s75, 5120
    s_add_u32 s62, s62, 0x20000
    buffer_load_dwordx4 v6, s[44:47], s62 offen nt lds
    s_add_u32 m0, s75, 6144
    s_add_u32 s62, s62, 0x20000
    buffer_load_dwordx4 v6, s[44:47], s62 offen nt lds
    s_add_u32 m0, s75, 7168
    s_add_u32 s62, s62, 0x20000
    buffer_load_dwordx4 v6, s[44:47], s62 offen nt lds
    buffer_load_dwordx4 v[144:147], v7, s[48:51], s73 offen offset:0
    buffer_load_dwordx4 v[148:151], v7, s[48:51], s73 offen offset:64
    buffer_load_dwordx4 v[152:155], v7, s[48:51], s73 offen offset:128
    buffer_load_dwordx4 v[156:159], v7, s[48:51], s73 offen offset:192
    s_mov_b32 s40, s28
    s_mov_b32 s41, s29
    s_mov_b32 s42, 3670016
    s_mov_b32 s43, 0x20000
    s_load_dword s64, s[28:29], 0
    s_cmp_lt_u32 s2, 16
    s_cbranch_scc0 L_noctr
    s_lshl_b32 s68, s2, 2
    s_add_u32 s68, s68, s3
    s_lshl_b32 s68, s68, 8
    s_add_u32 s68, s68, 16384
    v_mov_b32 v8, 0
    s_mov_b64 exec, 1
    buffer_store_dword v8, off, s[40:43], s68 sc1
    s_mov_b64 exec, -1
L_noctr:
    s_cmp_eq_u32 s97, 0
    s_cselect_b32 s30, s12, s22
    s_cselect_b32 s31, s13, s23
    s_add_u32 s32, s16, s72
    s_addc_u32 s33, s17, 0
    s_mov_b32 s34, 1048576
    s_mov_b32 s35, 0x20000
    s_add_u32 s36, s18, s72
    s_addc_u32 s37, s19, 0
    s_mov_b32 s38, 1048576
    s_mov_b32 s39, 0x20000
    s_lshl_b32 s92, s58, 14
    s_add_u32 s92, s92, s60
    s_add_u32 s52, s6, s69
    s_addc_u32 s53, s7, 0
    s_add_u32 s54, s8, s69
    s_addc_u32 s55, s9, 0
    v_lshlrev_b32 v17, 2, v1
    s_mov_b32 s61, s92
    buffer_load_dwordx4 a[0:3], v2, s[32:35], s61 offen offset:0 nt
    buffer_load_dwordx4 a[4:7], v2, s[32:35], s61 offen offset:64 nt
    buffer_load_dwordx4 a[8:11], v2, s[32:35], s61 offen offset:128 nt
    buffer_load_dwordx4 a[12:15], v2, s[32:35], s61 offen offset:192 nt
    buffer_load_dwordx4 v[64:67], v3, s[36:39], s61 offen offset:0 nt
    buffer_load_dwordx4 v[68:71], v3, s[36:39], s61 offen offset:256 nt
    buffer_load_dwordx4 v[72:75], v3, s[36:39], s61 offen offset:512 nt
    buffer_load_dwordx4 v[76:79], v3, s[36:39], s61 offen offset:768 nt
    s_add_u32 s61, s92, 262144
    buffer_load_dwordx4 a[16:19], v2, s[32:35], s61 offen offset:0 nt
    buffer_load_dwordx4 a[20:23], v2, s[32:35], s61 offen offset:64 nt
    buffer_load_dwordx4 a[24:27], v2, s[32:35], s61 offen offset:128 nt
    buffer_load_dwordx4 a[28:31], v2, s[32:35], s61 offen offset:192 nt
    v_mov_b32 v13, 35840
    v_mov_b32 v14, 0
    v_mov_b32 v15, 0
    ds_write_b64 v13, v[14:15]
    s_waitcnt lgkmcnt(0)
    s_barrier
    s_mov_b32 s65, 0x3e0293ee
    s_mov_b32 s66, 0x05040100
    s_mov_b32 s67, 0x07060302
    s_mov_b32 s70, 0x000f000f
    s_mov_b32 s71, 0x000f000f
    v_lshrrev_b32 v9, 2, v5
    v_lshlrev_b32 v9, 6, v9
    v_and_b32 v10, 3, v5
    v_lshl_add_u32 v9, v10, 3, v9
    v_lshl_add_u32 v9, v4, 9, v9
    v_add_u32 v9, s75, v9
    s_waitcnt vmcnt(12) lgkmcnt(0)
    buffer_load_dwordx4 v[80:83], v3, s[36:39], s61 offen offset:0 nt
    buffer_load_dwordx4 v[84:87], v3, s[36:39], s61 offen offset:256 nt
    buffer_load_dwordx4 v[88:91], v3, s[36:39], s61 offen offset:512 nt
    buffer_load_dwordx4 v[92:95], v3, s[36:39], s61 offen offset:768 nt
    ds_read_b64_tr_b16 v[192:193], v9 offset:0
    ds_read_b64_tr_b16 v[194:195], v9 offset:256
    ds_read_b64_tr_b16 v[196:197], v9 offset:32
    ds_read_b64_tr_b16 v[198:199], v9 offset:288
    ds_read_b64_tr_b16 v[200:201], v9 offset:2048
    ds_read_b64_tr_b16 v[202:203], v9 offset:2304
    ds_read_b64_tr_b16 v[204:205], v9 offset:2080
    ds_read_b64_tr_b16 v[206:207], v9 offset:2336
    ds_read_b64_tr_b16 v[208:209], v9 offset:4096
    ds_read_b64_tr_b16 v[210:211], v9 offset:4352
    ds_read_b64_tr_b16 v[212:213], v9 offset:4128
    ds_read_b64_tr_b16 v[214:215], v9 offset:4384
    ds_read_b64_tr_b16 v[216:217], v9 offset:6144
    ds_read_b64_tr_b16 v[218:219], v9 offset:6400
    ds_read_b64_tr_b16 v[220:221], v9 offset:6176
    ds_read_b64_tr_b16 v[222:223], v9 offset:6432
    s_mul_i32 s64, s64, 0x9E3779B1
    s_add_u32 s64, s64, 0x7F4A7C15
    s_waitcnt lgkmcnt(12)
    v_mfma_f32_16x16x32_bf16 v[160:163], v[144:147], v[192:195], 0
    v_mfma_f32_16x16x32_bf16 v[164:167], v[144:147], v[196:199], 0
    s_waitcnt lgkmcnt(8)
    v_mfma_f32_16x16x32_bf16 v[160:163], v[148:151], v[200:203], v[160:163]
    v_mfma_f32_16x16x32_bf16 v[164:167], v[148:151], v[204:207], v[164:167]
    s_waitcnt lgkmcnt(4)
    v_mfma_f32_16x16x32_bf16 v[160:163], v[152:155], v[208:211], v[160:163]
    v_mfma_f32_16x16x32_bf16 v[164:167], v[152:155], v[212:215], v[164:167]
    s_waitcnt lgkmcnt(0)
    v_mfma_f32_16x16x32_bf16 v[160:163], v[156:159], v[216:219], v[160:163]
    v_mfma_f32_16x16x32_bf16 v[164:167], v[156:159], v[220:223], v[164:167]
    s_lshl_b32 s62, s3, 8
    s_add_u32 s62, s62, 32768
    v_add_u32 v10, s62, v17
    s_mov_b64 exec, 0xffff
    s_nop 2
    ds_write_b32 v10, v160 offset:0
    ds_write_b32 v10, v161 offset:128
    ds_write_b32 v10, v164 offset:64
    ds_write_b32 v10, v165 offset:192
    s_mov_b64 exec, 1
    v_mov_b32 v14, 1
    ds_add_rtn_u32 v15, v13, v14 offset:4
    s_waitcnt lgkmcnt(0)
    v_readfirstlane_b32 s68, v15
    s_mov_b64 exec, -1
    s_cmp_eq_u32 s68, 3
    s_cbranch_scc0 L_nopub
    v_lshrrev_b32 v10, 4, v1
    v_lshlrev_b32 v10, 7, v10
    v_lshl_add_u32 v10, v5, 3, v10
    s_mov_b32 exec_lo, -1
    s_mov_b32 exec_hi, 0
    ds_read_b64 v[18:19], v10 offset:32768
    ds_read_b64 v[20:21], v10 offset:33024
    ds_read_b64 v[22:23], v10 offset:33280
    ds_read_b64 v[24:25], v10 offset:33536
    v_lshlrev_b32 v11, 11, v4
    v_lshl_add_u32 v11, v5, 3, v11
    s_lshl_b32 s62, s97, 3
    s_add_u32 s62, s62, s96
    s_lshl_b32 s62, s62, 12
    s_lshl_b32 s68, s98, 7
    s_add_u32 s62, s62, s68
    s_add_u32 s62, s62, 65536
    s_waitcnt lgkmcnt(0)
    v_add_f32 v18, v18, v20
    v_add_f32 v19, v19, v21
    v_add_f32 v22, v22, v24
    v_add_f32 v23, v23, v25
    v_add_f32 v18, v18, v22
    v_add_f32 v19, v19, v23
    v_cvt_pk_bf16_f32 v18, v18, v19
    v_mov_b32 v19, s64
    buffer_store_dwordx2 v[18:19], v11, s[40:43], s62 offen sc1
    s_mov_b64 exec, -1
L_nopub:
    v_lshlrev_b32 v10, 3, v0
    s_lshl_b32 s68, s57, 12
    s_lshl_b32 s69, s56, 11
    s_add_u32 s68, s68, s69
    s_add_u32 s90, s68, 65536
    s_add_u32 s91, s90, 0x8000
    v_lshlrev_b32 v11, 2, v0
    v_mov_b32 v13, 35840
    v_mov_b32 v14, 1
    s_mov_b32 s74, 0
    s_add_u32 s61, s92, 524288
    s_waitcnt vmcnt(8)
    buffer_load_dwordx4 a[32:35], v2, s[32:35], s61 offen offset:0 nt
    s_waitcnt vmcnt(8)
    buffer_load_dwordx4 a[36:39], v2, s[32:35], s61 offen offset:64 nt
    s_waitcnt vmcnt(8)
    buffer_load_dwordx4 a[40:43], v2, s[32:35], s61 offen offset:128 nt
    v_and_b32 v12, 3, v5
    v_lshlrev_b32 v12, 8, v12
    v_lshl_add_u32 v190, v4, 4, v12
    v_mov_b32 v32, 0
    v_mov_b32 v33, 0
    v_mov_b32 v34, 0
    v_mov_b32 v35, 0
    v_mov_b32 v36, 0
    v_mov_b32 v37, 0
    v_mov_b32 v38, 0
    v_mov_b32 v39, 0
    v_mov_b32 v40, 0
    v_mov_b32 v41, 0
    v_mov_b32 v42, 0
    v_mov_b32 v43, 0
    v_mov_b32 v44, 0
    v_mov_b32 v45, 0
    v_mov_b32 v46, 0
    v_mov_b32 v47, 0
    v_mov_b32 v48, 0
    v_mov_b32 v49, 0
    v_mov_b32 v50, 0
    v_mov_b32 v51, 0
    v_mov_b32 v52, 0
    v_mov_b32 v53, 0
    v_mov_b32 v54, 0
    v_mov_b32 v55, 0
    v_mov_b32 v56, 0
    v_mov_b32 v57, 0
    v_mov_b32 v58, 0
    v_mov_b32 v59, 0
    v_mov_b32 v60, 0
    v_mov_b32 v61, 0
    v_mov_b32 v62, 0
    v_mov_b32 v63, 0
    v_mov_b32 v184, 0xff800000
    v_mov_b32 v185, 0
    s_mul_i32 s62, s3, 2112
    s_add_u32 s62, s62, 36864
    v_mul_u32_u24 v191, 528, v5
    v_add_u32 v191, s62, v191
    v_lshl_add_u32 v189, v4, 7, v191
    s_lshl_b32 s93, s63, 2
    s_lshl_b32 s93, s93, 8
    s_add_u32 s93, s93, 16384
    s_add_u32 s100, s28, s93
    s_addc_u32 s101, s29, 0
    s_mov_b32 s99, 0
    s_mov_b32 s59, 0
    s_lshl_b32 s95, s58, 2
    s_add_u32 s95, s95, s3
    s_waitcnt vmcnt(8)
    buffer_load_dwordx4 a[44:47], v2, s[32:35], s61 offen offset:192 nt
    s_waitcnt vmcnt(8)
    buffer_load_dwordx4 v[96:99], v3, s[36:39], s61 offen offset:0 nt
    s_waitcnt vmcnt(8)
    buffer_load_dwordx4 v[100:103], v3, s[36:39], s61 offen offset:256 nt
    s_waitcnt vmcnt(8)
    buffer_load_dwordx4 v[104:107], v3, s[36:39], s61 offen offset:512 nt
    s_waitcnt vmcnt(8)
    buffer_load_dwordx4 v[108:111], v3, s[36:39], s61 offen offset:768 nt
    s_add_u32 s61, s92, 786432
    s_waitcnt vmcnt(8)
    buffer_load_dwordx4 a[48:51], v2, s[32:35], s61 offen offset:0 nt
    s_waitcnt vmcnt(8)
    buffer_load_dwordx4 a[52:55], v2, s[32:35], s61 offen offset:64 nt
    s_waitcnt vmcnt(8)
    buffer_load_dwordx4 a[56:59], v2, s[32:35], s61 offen offset:128 nt
    s_waitcnt vmcnt(8)
    buffer_load_dwordx4 a[60:63], v2, s[32:35], s61 offen offset:192 nt
    s_waitcnt vmcnt(8)
    buffer_load_dwordx4 v[112:115], v3, s[36:39], s61 offen offset:0 nt
    s_waitcnt vmcnt(8)
    buffer_load_dwordx4 v[116:119], v3, s[36:39], s61 offen offset:256 nt
    s_waitcnt vmcnt(8)
    buffer_load_dwordx4 v[120:123], v3, s[36:39], s61 offen offset:512 nt
    s_waitcnt vmcnt(8)
    buffer_load_dwordx4 v[124:127], v3, s[36:39], s61 offen offset:768 nt
    buffer_load_dwordx2 v[20:21], v10, s[40:43], s90 offen sc1
    buffer_load_dwordx2 v[22:23], v10, s[40:43], s91 offen sc1
    s_mov_b32 s32, s52
    s_mov_b32 s33, s53
    s_mov_b32 s34, 0x800000
    s_mov_b32 s36, s54
    s_mov_b32 s37, s55
    s_mov_b32 s38, 0x800000
    s_lshl_b32 s61, s58, 14
    s_add_u32 s61, s61, s60
    s_waitcnt vmcnt(8)
    buffer_load_dwordx4 a[96:99], v2, s[32:35], s61 offen offset:0 nt
    s_waitcnt vmcnt(8)
    buffer_load_dwordx4 a[100:103], v2, s[32:35], s61 offen offset:64 nt
    s_waitcnt vmcnt(8)
    buffer_load_dwordx4 a[104:107], v2, s[32:35], s61 offen offset:128 nt
    s_waitcnt vmcnt(8)
    buffer_load_dwordx4 a[108:111], v2, s[32:35], s61 offen offset:192 nt
    s_waitcnt vmcnt(8)
    buffer_load_dwordx4 v[128:131], v3, s[36:39], s61 offen offset:0 nt
    s_waitcnt vmcnt(8)
    buffer_load_dwordx4 v[132:135], v3, s[36:39], s61 offen offset:256 nt
    s_waitcnt vmcnt(8)
    buffer_load_dwordx4 v[136:139], v3, s[36:39], s61 offen offset:512 nt
    s_waitcnt vmcnt(8)
    buffer_load_dwordx4 v[140:143], v3, s[36:39], s61 offen offset:768 nt
    s_mov_b32 s74, 65536
    s_waitcnt vmcnt(8)
    s_branch L_qchk1
L_qchk:
    s_waitcnt vmcnt(0)
L_qchk1:
    v_cmp_ne_u32 vcc, s64, v21
    v_cmp_ne_u32 s[78:79], s64, v23
    s_nop 0
    s_or_b64 vcc, vcc, s[78:79]
    s_cbranch_vccz L_qsh
    s_sub_u32 s74, s74, 1
    s_cbranch_scc1 L_qsh
    buffer_load_dwordx2 v[20:21], v10, s[40:43], s90 offen sc1
    buffer_load_dwordx2 v[22:23], v10, s[40:43], s91 offen sc1
    s_branch L_qchk
L_qsh:
    ds_write_b32 v11, v20 offset:33792
    ds_write_b32 v11, v22 offset:34816
    s_mov_b64 exec, 1
    ds_add_u32 v13, v14
    s_mov_b64 exec, -1
L_qok:
    s_mov_b32 s74, 4194304
L_qw:
    ds_read_b32 v12, v13
    s_waitcnt lgkmcnt(0)
    v_readfirstlane_b32 s68, v12
    s_nop 0
    s_cmp_eq_u32 s68, 4
    s_cbranch_scc1 L_qw_ok
    s_sub_u32 s74, s74, 1
    s_cbranch_scc0 L_qw
L_qw_ok:
    ds_read_b128 a[80:83], v190 offset:33792
    ds_read_b128 a[84:87], v190 offset:33856
    ds_read_b128 a[88:91], v190 offset:33920
    ds_read_b128 a[92:95], v190 offset:33984
    ds_read_b128 a[64:67], v190 offset:34816
    ds_read_b128 a[68:71], v190 offset:34880
    ds_read_b128 a[72:75], v190 offset:34944
    ds_read_b128 a[76:79], v190 offset:35008
    s_waitcnt lgkmcnt(0)
L_loop:
    s_waitcnt vmcnt(4)
    v_mfma_f32_16x16x32_bf16 v[160:163], a[96:99], a[80:83], 0
    v_mfma_f32_16x16x32_bf16 v[160:163], a[100:103], a[84:87], v[160:163]
    v_mfma_f32_16x16x32_bf16 v[160:163], a[104:107], a[88:91], v[160:163]
    v_mfma_f32_16x16x32_bf16 v[160:163], a[108:111], a[92:95], v[160:163]
    s_add_u32 s72, s95, 64
    s_add_u32 s59, s59, 1
    s_waitcnt lgkmcnt(0)
    s_mov_b32 s68, s99
    s_add_u32 s68, s68, 1920
    s_cmp_lt_u32 s59, 30
    s_cselect_b32 s95, s72, s68
    s_cmp_lt_u32 s95, 2048
    s_cbranch_scc0 L_fin1e
    s_lshl_b32 s61, s95, 12
    buffer_load_dwordx4 a[96:99], v2, s[32:35], s61 offen offset:0 nt
    buffer_load_dwordx4 a[100:103], v2, s[32:35], s61 offen offset:64 nt
    buffer_load_dwordx4 a[104:107], v2, s[32:35], s61 offen offset:128 nt
    buffer_load_dwordx4 a[108:111], v2, s[32:35], s61 offen offset:192 nt
    s_cmp_ge_u32 s59, 29
    s_cbranch_scc0 L_fin1e
    s_mov_b32 s99, 1
    s_atomic_add s99, s[100:101], 0x0 glc
L_fin1e:
    v_max3_f32 v187, v160, v161, v162
    v_max_f32 v187, v187, v163
    v_mov_b32 v188, v187
    s_nop 1
    v_permlane32_swap_b32 v187, v188
    v_max_f32 v187, v187, v188
    v_mov_b32 v188, v187
    s_nop 1
    v_permlane16_swap_b32 v187, v188
    v_max_f32 v187, v187, v188
    v_mul_f32 v187, s65, v187
    v_max_f32 v187, v187, v184
    v_sub_f32 v186, v184, v187
    v_mov_b32 v184, v187
    v_exp_f32 v186, v186
    v_fma_f32 v160, v160, s65, -v187
    v_fma_f32 v161, v161, s65, -v187
    v_fma_f32 v162, v162, s65, -v187
    v_fma_f32 v163, v163, s65, -v187
    v_exp_f32 v160, v160
    v_exp_f32 v161, v161
    v_exp_f32 v162, v162
    v_exp_f32 v163, v163
    v_cvt_pk_bf16_f32 v176, v160, v161
    v_cvt_pk_bf16_f32 v177, v162, v163
    v_add_f32 v160, v160, v161
    v_add_f32 v162, v162, v163
    v_add_f32 v160, v160, v162
    v_fma_f32 v185, v185, v186, v160
    v_mul_f32 v32, v186, v32
    v_mul_f32 v33, v186, v33
    v_mul_f32 v34, v186, v34
    v_mul_f32 v35, v186, v35
    v_mul_f32 v36, v186, v36
    v_mul_f32 v37, v186, v37
    v_mul_f32 v38, v186, v38
    v_mul_f32 v39, v186, v39
    v_mul_f32 v40, v186, v40
    v_mul_f32 v41, v186, v41
    v_mul_f32 v42, v186, v42
    v_mul_f32 v43, v186, v43
    v_mul_f32 v44, v186, v44
    v_mul_f32 v45, v186, v45
    v_mul_f32 v46, v186, v46
    v_mul_f32 v47, v186, v47
    v_mul_f32 v48, v186, v48
    v_mul_f32 v49, v186, v49
    v_mul_f32 v50, v186, v50
    v_mul_f32 v51, v186, v51
    v_mul_f32 v52, v186, v52
    v_mul_f32 v53, v186, v53
    v_mul_f32 v54, v186, v54
    v_mul_f32 v55, v186, v55
    v_mul_f32 v56, v186, v56
    v_mul_f32 v57, v186, v57
    v_mul_f32 v58, v186, v58
    v_mul_f32 v59, v186, v59
    v_mul_f32 v60, v186, v60
    v_mul_f32 v61, v186, v61
    v_mul_f32 v62, v186, v62
    v_mul_f32 v63, v186, v63
    s_cmp_lt_u32 s95, 2048
    s_cbranch_scc1 L_w5
    buffer_load_dwordx4 v[64:67], v205, s[44:47], s8 offen offset:0 nt
    buffer_load_dwordx4 v[68:71], v205, s[44:47], s9 offen offset:0 nt
    buffer_load_dwordx4 v[72:75], v205, s[44:47], s10 offen offset:0 nt
    buffer_load_dwordx4 v[76:79], v205, s[44:47], s11 offen offset:0 nt
    buffer_load_dwordx4 v[80:83], v205, s[44:47], s8 offen offset:1024 nt
    buffer_load_dwordx4 v[84:87], v205, s[44:47], s9 offen offset:1024 nt
    buffer_load_dwordx4 v[88:91], v205, s[44:47], s10 offen offset:1024 nt
    buffer_load_dwordx4 v[92:95], v205, s[44:47], s11 offen offset:1024 nt
    v_mov_b32 v188, v185
    s_nop 1
    v_permlane32_swap_b32 v185, v188
    v_add_f32 v185, v185, v188
    v_mov_b32 v188, v185
    s_nop 1
    v_permlane16_swap_b32 v185, v188
    v_add_f32 v185, v185, v188
    s_waitcnt vmcnt(8)
    s_branch L_w5e
L_w5:
    s_waitcnt vmcnt(4)
L_w5e:
    v_perm_b32 v144, v132, v128, s66
    v_perm_b32 v145, v140, v136, s66
    v_perm_b32 v146, v132, v128, s67
    v_perm_b32 v147, v140, v136, s67
    v_perm_b32 v148, v133, v129, s66
    v_perm_b32 v149, v141, v137, s66
    v_perm_b32 v150, v133, v129, s67
    v_perm_b32 v151, v141, v137, s67
    v_perm_b32 v152, v134, v130, s66
    v_perm_b32 v153, v142, v138, s66
    v_perm_b32 v154, v134, v130, s67
    v_perm_b32 v155, v142, v138, s67
    v_perm_b32 v156, v135, v131, s66
    v_perm_b32 v157, v143, v139, s66
    v_perm_b32 v158, v135, v131, s67
    v_perm_b32 v159, v143, v139, s67
    s_cmp_lt_u32 s95, 2048
    s_cbranch_scc0 L_fin2e
    buffer_load_dwordx4 v[128:131], v3, s[36:39], s61 offen offset:0 nt
    buffer_load_dwordx4 v[132:135], v3, s[36:39], s61 offen offset:256 nt
    buffer_load_dwordx4 v[136:139], v3, s[36:39], s61 offen offset:512 nt
    buffer_load_dwordx4 v[140:143], v3, s[36:39], s61 offen offset:768 nt
L_fin2e:
    v_mfma_f32_16x16x16_bf16 v[32:35], v[144:145], v[176:177], v[32:35]
    v_mfma_f32_16x16x16_bf16 v[36:39], v[146:147], v[176:177], v[36:39]
    v_mfma_f32_16x16x16_bf16 v[40:43], v[148:149], v[176:177], v[40:43]
    v_mfma_f32_16x16x16_bf16 v[44:47], v[150:151], v[176:177], v[44:47]
    v_mfma_f32_16x16x16_bf16 v[48:51], v[152:153], v[176:177], v[48:51]
    v_mfma_f32_16x16x16_bf16 v[52:55], v[154:155], v[176:177], v[52:55]
    v_mfma_f32_16x16x16_bf16 v[56:59], v[156:157], v[176:177], v[56:59]
    v_mfma_f32_16x16x16_bf16 v[60:63], v[158:159], v[176:177], v[60:63]
    s_cmp_lt_u32 s95, 2048
    s_cbranch_scc0 L_exit
    s_cmp_eq_u32 s59, 1
    s_cbranch_scc0 L_loop
L_bshot:
    v_mfma_f32_16x16x32_bf16 v[160:163], a[0:3], a[64:67], 0
    v_mfma_f32_16x16x32_bf16 v[160:163], a[4:7], a[68:71], v[160:163]
    v_mfma_f32_16x16x32_bf16 v[160:163], a[8:11], a[72:75], v[160:163]
    v_mfma_f32_16x16x32_bf16 v[160:163], a[12:15], a[76:79], v[160:163]
    v_mfma_f32_16x16x32_bf16 v[164:167], a[16:19], a[64:67], 0
    v_mfma_f32_16x16x32_bf16 v[164:167], a[20:23], a[68:71], v[164:167]
    v_mfma_f32_16x16x32_bf16 v[164:167], a[24:27], a[72:75], v[164:167]
    v_mfma_f32_16x16x32_bf16 v[164:167], a[28:31], a[76:79], v[164:167]
    v_mfma_f32_16x16x32_bf16 v[168:171], a[32:35], a[64:67], 0
    v_mfma_f32_16x16x32_bf16 v[168:171], a[36:39], a[68:71], v[168:171]
    v_mfma_f32_16x16x32_bf16 v[168:171], a[40:43], a[72:75], v[168:171]
    v_mfma_f32_16x16x32_bf16 v[168:171], a[44:47], a[76:79], v[168:171]
    v_mfma_f32_16x16x32_bf16 v[172:175], a[48:51], a[64:67], 0
    v_mfma_f32_16x16x32_bf16 v[172:175], a[52:55], a[68:71], v[172:175]
    v_mfma_f32_16x16x32_bf16 v[172:175], a[56:59], a[72:75], v[172:175]
    v_mfma_f32_16x16x32_bf16 v[172:175], a[60:63], a[76:79], v[172:175]
    v_max3_f32 v187, v160, v161, v162
    v_max3_f32 v187, v187, v163, v164
    v_max3_f32 v187, v187, v165, v166
    s_nop 0
    v_max3_f32 v187, v187, v167, v168
    v_max3_f32 v187, v187, v169, v170
    s_nop 1
    v_max3_f32 v187, v187, v171, v172
    v_max3_f32 v187, v187, v173, v174
    v_max_f32 v187, v187, v175
    v_mov_b32 v188, v187
    s_nop 1
    v_permlane32_swap_b32 v187, v188
    v_max_f32 v187, v187, v188
    v_mov_b32 v188, v187
    s_nop 1
    v_permlane16_swap_b32 v187, v188
    v_max_f32 v187, v187, v188
    v_mul_f32 v26, s65, v187
    v_fma_f32 v160, v160, s65, -v26
    v_fma_f32 v161, v161, s65, -v26
    v_fma_f32 v162, v162, s65, -v26
    v_fma_f32 v163, v163, s65, -v26
    v_fma_f32 v164, v164, s65, -v26
    v_fma_f32 v165, v165, s65, -v26
    v_fma_f32 v166, v166, s65, -v26
    v_fma_f32 v167, v167, s65, -v26
    v_fma_f32 v168, v168, s65, -v26
    v_fma_f32 v169, v169, s65, -v26
    v_fma_f32 v170, v170, s65, -v26
    v_fma_f32 v171, v171, s65, -v26
    v_fma_f32 v172, v172, s65, -v26
    v_fma_f32 v173, v173, s65, -v26
    v_fma_f32 v174, v174, s65, -v26
    v_fma_f32 v175, v175, s65, -v26
    v_exp_f32 v160, v160
    v_exp_f32 v161, v161
    v_exp_f32 v162, v162
    v_exp_f32 v163, v163
    v_exp_f32 v164, v164
    v_exp_f32 v165, v165
    v_exp_f32 v166, v166
    v_exp_f32 v167, v167
    v_exp_f32 v168, v168
    v_exp_f32 v169, v169
    v_exp_f32 v170, v170
    v_exp_f32 v171, v171
    v_exp_f32 v172, v172
    v_exp_f32 v173, v173
    v_exp_f32 v174, v174
    v_exp_f32 v175, v175
    v_cvt_pk_bf16_f32 v176, v160, v161
    v_cvt_pk_bf16_f32 v177, v162, v163
    v_cvt_pk_bf16_f32 v178, v164, v165
    v_cvt_pk_bf16_f32 v179, v166, v167
    v_cvt_pk_bf16_f32 v180, v168, v169
    v_cvt_pk_bf16_f32 v181, v170, v171
    v_cvt_pk_bf16_f32 v182, v172, v173
    v_cvt_pk_bf16_f32 v183, v174, v175
    v_add_f32 v160, v160, v168
    v_add_f32 v161, v161, v169
    v_add_f32 v162, v162, v170
    v_add_f32 v163, v163, v171
    v_add_f32 v164, v164, v172
    v_add_f32 v165, v165, v173
    v_add_f32 v166, v166, v174
    v_add_f32 v167, v167, v175
    v_add_f32 v160, v160, v164
    v_add_f32 v161, v161, v165
    v_add_f32 v162, v162, v166
    v_add_f32 v163, v163, v167
    v_add_f32 v160, v160, v161
    v_add_f32 v162, v162, v163
    v_add_f32 v27, v160, v162
    v_mov_b32 v188, v27
    s_nop 1
    v_permlane32_swap_b32 v27, v188
    v_add_f32 v27, v27, v188
    v_mov_b32 v188, v27
    s_nop 1
    v_permlane16_swap_b32 v27, v188
    v_add_f32 v27, v27, v188
    v_perm_b32 v144, v68, v64, s66
    v_perm_b32 v145, v76, v72, s66
    v_perm_b32 v146, v84, v80, s66
    v_perm_b32 v147, v92, v88, s66
    v_perm_b32 v148, v68, v64, s67
    v_perm_b32 v149, v76, v72, s67
    v_perm_b32 v150, v84, v80, s67
    v_perm_b32 v151, v92, v88, s67
    v_mfma_f32_16x16x32_bf16 v[192:195], v[144:147], v[176:179], 0
    v_perm_b32 v152, v69, v65, s66
    v_perm_b32 v153, v77, v73, s66
    v_perm_b32 v154, v85, v81, s66
    v_perm_b32 v155, v93, v89, s66
    v_mfma_f32_16x16x32_bf16 v[196:199], v[148:151], v[176:179], 0
    v_perm_b32 v156, v69, v65, s67
    v_perm_b32 v157, v77, v73, s67
    v_perm_b32 v158, v85, v81, s67
    v_perm_b32 v159, v93, v89, s67
    v_mfma_f32_16x16x32_bf16 v[200:203], v[152:155], v[176:179], 0
    v_perm_b32 v144, v70, v66, s66
    v_perm_b32 v145, v78, v74, s66
    v_perm_b32 v146, v86, v82, s66
    v_perm_b32 v147, v94, v90, s66
    v_mfma_f32_16x16x32_bf16 v[204:207], v[156:159], v[176:179], 0
    v_perm_b32 v148, v70, v66, s67
    v_perm_b32 v149, v78, v74, s67
    v_perm_b32 v150, v86, v82, s67
    v_perm_b32 v151, v94, v90, s67
    v_mfma_f32_16x16x32_bf16 v[208:211], v[144:147], v[176:179], 0
    v_perm_b32 v152, v71, v67, s66
    v_perm_b32 v153, v79, v75, s66
    v_perm_b32 v154, v87, v83, s66
    v_perm_b32 v155, v95, v91, s66
    v_mfma_f32_16x16x32_bf16 v[212:215], v[148:151], v[176:179], 0
    v_perm_b32 v156, v71, v67, s67
    v_perm_b32 v157, v79, v75, s67
    v_perm_b32 v158, v87, v83, s67
    v_perm_b32 v159, v95, v91, s67
    v_mfma_f32_16x16x32_bf16 v[216:219], v[152:155], v[176:179], 0
    v_perm_b32 v144, v100, v96, s66
    v_perm_b32 v145, v108, v104, s66
    v_perm_b32 v146, v116, v112, s66
    v_perm_b32 v147, v124, v120, s66
    v_mfma_f32_16x16x32_bf16 v[220:223], v[156:159], v[176:179], 0
    v_perm_b32 v148, v100, v96, s67
    v_perm_b32 v149, v108, v104, s67
    v_perm_b32 v150, v116, v112, s67
    v_perm_b32 v151, v124, v120, s67
    v_mfma_f32_16x16x32_bf16 v[192:195], v[144:147], v[180:183], v[192:195]
    v_perm_b32 v152, v101, v97, s66
    v_perm_b32 v153, v109, v105, s66
    v_perm_b32 v154, v117, v113, s66
    v_perm_b32 v155, v125, v121, s66
    v_mfma_f32_16x16x32_bf16 v[196:199], v[148:151], v[180:183], v[196:199]
    v_perm_b32 v156, v101, v97, s67
    v_perm_b32 v157, v109, v105, s67
    v_perm_b32 v158, v117, v113, s67
    v_perm_b32 v159, v125, v121, s67
    v_mfma_f32_16x16x32_bf16 v[200:203], v[152:155], v[180:183], v[200:203]
    v_perm_b32 v144, v102, v98, s66
    v_perm_b32 v145, v110, v106, s66
    v_perm_b32 v146, v118, v114, s66
    v_perm_b32 v147, v126, v122, s66
    v_mfma_f32_16x16x32_bf16 v[204:207], v[156:159], v[180:183], v[204:207]
    v_perm_b32 v148, v102, v98, s67
    v_perm_b32 v149, v110, v106, s67
    v_perm_b32 v150, v118, v114, s67
    v_perm_b32 v151, v126, v122, s67
    v_mfma_f32_16x16x32_bf16 v[208:211], v[144:147], v[180:183], v[208:211]
    v_perm_b32 v152, v103, v99, s66
    v_perm_b32 v153, v111, v107, s66
    v_perm_b32 v154, v119, v115, s66
    v_perm_b32 v155, v127, v123, s66
    v_mfma_f32_16x16x32_bf16 v[212:215], v[148:151], v[180:183], v[212:215]
    v_perm_b32 v156, v103, v99, s67
    v_perm_b32 v157, v111, v107, s67
    v_perm_b32 v158, v119, v115, s67
    v_perm_b32 v159, v127, v123, s67
    v_mfma_f32_16x16x32_bf16 v[216:219], v[152:155], v[180:183], v[216:219]
    s_nop 0
    v_mfma_f32_16x16x32_bf16 v[220:223], v[156:159], v[180:183], v[220:223]
    v_add_u32 v28, 8448, v189
    v_add_u32 v29, 8448, v191
    s_mov_b64 exec, s[70:71]
    ds_write_b128 v28, v[192:195] offset:0
    ds_write_b128 v28, v[196:199] offset:16
    ds_write_b128 v28, v[200:203] offset:32
    ds_write_b128 v28, v[204:207] offset:48
    ds_write_b128 v28, v[208:211] offset:64
    ds_write_b128 v28, v[212:215] offset:80
    ds_write_b128 v28, v[216:219] offset:96
    ds_write_b128 v28, v[220:223] offset:112
    ds_write_b64 v29, v[26:27] offset:512
    s_mov_b64 exec, -1
    s_waitcnt lgkmcnt(0)
    v_lshrrev_b32 v12, 7, v0
    v_bfe_u32 v13, v0, 5, 2
    v_and_b32 v14, 31, v0
    v_mul_u32_u24 v15, 8448, v12
    v_mul_u32_u24 v16, 528, v13
    v_add_u32 v15, v15, v16
    v_add_u32 v201, 36864, v15
    v_lshl_add_u32 v202, v14, 4, v201
    v_lshrrev_b32 v15, 3, v14
    v_lshl_add_u32 v15, v13, 2, v15
    v_lshl_add_u32 v15, v12, 4, v15
    v_lshlrev_b32 v15, 3, v15
    v_and_b32 v16, 7, v14
    v_mul_u32_u24 v203, 4096, v15
    v_lshl_add_u32 v203, v16, 4, v203
    v_lshrrev_b32 v204, 5, v0
    v_lshlrev_b32 v204, 9, v204
    v_cmp_eq_u32 s[6:7], 0, v14
    s_lshl_b32 s68, s56, 4
    s_add_u32 s68, s68, s58
    s_lshl_b32 s4, s57, 12
    s_lshl_b32 s69, s68, 4
    s_add_u32 s5, s4, s69
    s_add_u32 s5, s5, 131072
    s_mul_i32 s4, s57, 4096
    s_lshl_b32 s69, s68, 7
    s_add_u32 s4, s4, s69
    s_add_u32 s4, s4, 1048576
    s_mov_b32 s44, s30
    s_mov_b32 s45, s31
    s_lshl_b32 s8, s96, 19
    s_lshl_b32 s68, s98, 15
    s_add_u32 s8, s8, s68
    s_lshl_b32 s68, s3, 8
    s_add_u32 s8, s8, s68
    s_add_u32 s9, s8, 0x2000
    s_add_u32 s10, s8, 0x4000
    s_add_u32 s11, s8, 0x6000
    v_lshlrev_b32 v205, 4, v5
    v_lshl_add_u32 v205, v4, 11, v205
    v_lshlrev_b32 v206, 4, v0
    v_lshrrev_b32 v207, 3, v0
    v_lshlrev_b32 v207, 4, v207
    s_lshr_b32 s68, s3, 1
    s_lshl_b32 s68, s68, 8
    v_lshl_add_u32 v208, v5, 4, s68
    s_mul_i32 s12, s2, 4096
    s_add_u32 s12, s12, 1048576
    s_lshl_b32 s13, s96, 3
    s_lshl_b32 s68, s97, 2
    s_add_u32 s13, s13, s68
    s_lshr_b32 s69, s98, 2
    s_add_u32 s13, s13, s69
    s_lshl_b32 s13, s13, 9
    s_add_u32 s13, s13, 131072
    s_mul_i32 s68, s3, 144
    s_add_u32 s68, s68, 53760
    v_lshl_add_u32 v209, v1, 4, s68
    v_mov_b32 v210, s68
    v_and_b32 v212, 1, v1
    v_mul_u32_u24 v212, 288, v212
    v_lshl_add_u32 v211, v4, 5, v212
    v_lshrrev_b32 v15, 3, v5
    v_lshl_add_u32 v15, v4, 1, v15
    v_mul_u32_u24 v213, 16384, v15
    v_and_b32 v15, 7, v5
    v_lshl_add_u32 v213, v15, 4, v213
    s_lshl_b32 s14, s97, 5
    s_lshl_b32 s68, s3, 3
    s_add_u32 s14, s14, s68
    s_mul_i32 s14, s14, 16384
    s_lshl_b32 s68, s96, 4
    s_add_u32 s68, s68, s98
    s_lshl_b32 s68, s68, 7
    s_add_u32 s14, s14, s68
    s_add_u32 s14, s14, 2359296
    s_mov_b32 s16, 0xffff0000
    s_mov_b32 s17, 0
    s_mov_b32 s18, 0
    s_mov_b32 s19, 0xffff
    s_mov_b32 s20, 0
    s_mov_b32 s21, 0xffff0000
    v_lshlrev_b32 v214, 4, v1
    s_mul_i32 s15, s2, 16384
    s_lshl_b32 s68, s3, 12
    s_add_u32 s15, s15, s68
    s_add_u32 s15, s15, 2359296
    s_mov_b32 s48, s24
    s_mov_b32 s49, s25
    s_mov_b32 s50, 0x1000
    s_bfe_u32 s22, s2, 0x10005
    s_lshl_b32 s22, s22, 10
    s_bfe_u32 s68, s2, 0x20003
    s_lshl_b32 s68, s68, 8
    s_add_u32 s22, s22, s68
    s_bfe_u32 s68, s2, 0x20001
    s_lshl_b32 s68, s68, 2
    s_add_u32 s22, s22, s68
    s_and_b32 s68, s2, 1
    s_lshl_b32 s68, s68, 7
    s_add_u32 s22, s22, s68
    v_lshlrev_b32 v216, 4, v1
    s_lshl_b32 s68, s3, 7
    s_add_u32 s68, s68, 54400
    v_lshl_add_u32 v217, v1, 4, s68
    v_lshlrev_b32 v218, 4, v1
    v_add_u32 v218, 54400, v218
    s_movk_i32 s90, 0x3ff
    s_mov_b32 s91, 0xfffffc00
    v_mov_b32 v215, s64
    s_branch L_loop
L_exit:
    s_mov_b64 exec, s[70:71]
    ds_write_b128 v189, v[32:35] offset:0
    ds_write_b128 v189, v[36:39] offset:16
    ds_write_b128 v189, v[40:43] offset:32
    ds_write_b128 v189, v[44:47] offset:48
    ds_write_b128 v189, v[48:51] offset:64
    ds_write_b128 v189, v[52:55] offset:80
    ds_write_b128 v189, v[56:59] offset:96
    ds_write_b128 v189, v[60:63] offset:112
    ds_write_b64 v191, v[184:185] offset:512
    s_mov_b64 exec, -1
    v_mov_b32 v22, s64
    v_mov_b32 v23, s64
    s_waitcnt lgkmcnt(0)
    s_barrier
    ds_read_b64 v[12:13], v201 offset:512
    ds_read_b64 v[14:15], v201 offset:2624
    ds_read_b64 v[16:17], v201 offset:4736
    ds_read_b64 v[18:19], v201 offset:6848
    ds_read_b128 v[128:131], v202 offset:0
    ds_read_b128 v[132:135], v202 offset:2112
    ds_read_b128 v[136:139], v202 offset:4224
    ds_read_b128 v[140:143], v202 offset:6336
    s_waitcnt lgkmcnt(4)
    v_max3_f32 v20, v12, v14, v16
    v_max_f32 v20, v20, v18
    v_and_b32 v20, s91, v20
    v_sub_f32 v12, v12, v20
    v_sub_f32 v14, v14, v20
    v_sub_f32 v16, v16, v20
    v_sub_f32 v18, v18, v20
    v_exp_f32 v12, v12
    v_exp_f32 v14, v14
    v_exp_f32 v16, v16
    v_exp_f32 v18, v18
    v_bfi_b32 v20, s90, v215, v20
    s_waitcnt lgkmcnt(0)
    v_mul_f32 v24, v12, v128
    v_mul_f32 v25, v12, v129
    v_mul_f32 v26, v12, v130
    v_mul_f32 v27, v12, v131
    v_mul_f32 v21, v12, v13
    v_fmac_f32 v24, v14, v132
    v_fmac_f32 v25, v14, v133
    v_fmac_f32 v26, v14, v134
    v_fmac_f32 v27, v14, v135
    v_fmac_f32 v21, v14, v15
    v_fmac_f32 v24, v16, v136
    v_fmac_f32 v25, v16, v137
    v_fmac_f32 v26, v16, v138
    v_fmac_f32 v27, v16, v139
    v_fmac_f32 v21, v16, v17
    v_fmac_f32 v24, v18, v140
    v_fmac_f32 v25, v18, v141
    v_fmac_f32 v26, v18, v142
    v_fmac_f32 v27, v18, v143
    v_fmac_f32 v21, v18, v19
    v_bfi_b32 v24, s90, v215, v24
    v_bfi_b32 v25, s90, v215, v25
    v_bfi_b32 v26, s90, v215, v26
    v_bfi_b32 v27, s90, v215, v27
    v_bfi_b32 v21, s90, v215, v21
    buffer_store_dwordx4 v[24:27], v203, s[40:43], s4 offen sc1
    s_mov_b64 exec, s[6:7]
    buffer_store_dwordx4 v[20:23], v204, s[40:43], s5 offen sc1
    s_mov_b64 exec, -1
    buffer_load_dwordx4 v[220:223], v206, s[40:43], s12 offen sc1
    buffer_load_dwordx3 v[192:194], v207, s[40:43], s13 offen sc1
    buffer_load_dwordx3 v[196:198], v208, s[40:43], s13 offen sc1
    s_mov_b32 s74, 65536
    s_waitcnt vmcnt(0)
    s_branch L_p1c
L_p1:
    s_waitcnt vmcnt(0)
    s_mov_b64 exec, -1
L_p1c:
    v_xor_b32 v19, v215, v220
    v_bitop3_b32 v19, v19, v221, v215 bitop3:0xf6
    v_bitop3_b32 v19, v19, v222, v215 bitop3:0xf6
    v_bitop3_b32 v19, v19, v223, v215 bitop3:0xf6
    v_bitop3_b32 v19, v19, v192, v215 bitop3:0xf6
    v_bitop3_b32 v19, v19, v193, v215 bitop3:0xf6
    v_bitop3_b32 v19, v19, v196, v215 bitop3:0xf6
    v_bitop3_b32 v19, v19, v197, v215 bitop3:0xf6
    v_and_b32 v19, s90, v19
    v_bitop3_b32 v19, v19, v194, v215 bitop3:0xf6
    v_bitop3_b32 v19, v19, v198, v215 bitop3:0xf6
    v_cmp_ne_u32 vcc, 0, v19
    s_nop 0
    s_cbranch_vccz L_p1ok
    s_sub_u32 s74, s74, 1
    s_cbranch_scc1 L_p1ok
    s_mov_b64 exec, vcc
    buffer_load_dwordx4 v[220:223], v206, s[40:43], s12 offen sc1
    buffer_load_dwordx3 v[192:194], v207, s[40:43], s13 offen sc1
    buffer_load_dwordx3 v[196:198], v208, s[40:43], s13 offen sc1
    s_branch L_p1
L_p1ok:
    s_cmp_lt_u32 s2, 64
    s_cbranch_scc0 L_noe2
    buffer_load_dwordx4 v[128:131], v214, s[40:43], s15 offen offset:0 sc1
    buffer_load_dwordx4 v[132:135], v214, s[40:43], s15 offen offset:1024 sc1
    buffer_load_dwordx4 v[136:139], v214, s[40:43], s15 offen offset:2048 sc1
    buffer_load_dwordx4 v[140:143], v214, s[40:43], s15 offen offset:3072 sc1
L_noe2:
    v_and_b32 v16, s91, v196
    v_and_b32 v12, s91, v192
    v_and_b32 v17, s91, v197
    v_max_f32_dpp v14, v16, v16 row_ror:8 row_mask:0xf bank_mask:0xf
    v_and_b32 v8, s91, v220
    v_and_b32 v9, s91, v221
    v_max_f32_dpp v14, v14, v14 row_ror:4 row_mask:0xf bank_mask:0xf
    v_and_b32 v10, s91, v222
    v_and_b32 v11, s91, v223
    v_max_f32_dpp v14, v14, v14 row_ror:2 row_mask:0xf bank_mask:0xf
    s_nop 1
    v_max_f32_dpp v14, v14, v14 row_ror:1 row_mask:0xf bank_mask:0xf
    v_sub_f32 v12, v12, v14
    v_sub_f32 v16, v16, v14
    v_exp_f32 v12, v12
    v_exp_f32 v16, v16
    v_mul_f32 v8, v12, v8
    v_mul_f32 v9, v12, v9
    v_mul_f32 v10, v12, v10
    v_mul_f32 v11, v12, v11
    v_mul_f32 v17, v16, v17
    v_add_f32_dpp v8, v8, v8 row_ror:8 row_mask:0xf bank_mask:0xf
    v_add_f32_dpp v9, v9, v9 row_ror:8 row_mask:0xf bank_mask:0xf
    v_add_f32_dpp v10, v10, v10 row_ror:8 row_mask:0xf bank_mask:0xf
    v_add_f32_dpp v11, v11, v11 row_ror:8 row_mask:0xf bank_mask:0xf
    v_add_f32_dpp v17, v17, v17 row_ror:8 row_mask:0xf bank_mask:0xf
    v_mov_b32 v20, v8
    v_mov_b32 v21, v9
    v_mov_b32 v22, v10
    v_mov_b32 v23, v11
    v_add_f32_dpp v17, v17, v17 row_ror:4 row_mask:0xf bank_mask:0xf
    v_permlane16_swap_b32 v8, v20
    v_permlane16_swap_b32 v9, v21
    v_permlane16_swap_b32 v10, v22
    v_permlane16_swap_b32 v11, v23
    v_add_f32_dpp v17, v17, v17 row_ror:2 row_mask:0xf bank_mask:0xf
    v_add_f32 v8, v8, v20
    v_add_f32 v9, v9, v21
    v_add_f32 v10, v10, v22
    v_add_f32 v11, v11, v23
    v_add_f32_dpp v17, v17, v17 row_ror:1 row_mask:0xf bank_mask:0xf
    v_mov_b32 v20, v8
    v_mov_b32 v21, v9
    v_mov_b32 v22, v10
    v_mov_b32 v23, v11
    v_permlane32_swap_b32 v8, v20
    v_permlane32_swap_b32 v9, v21
    v_permlane32_swap_b32 v10, v22
    v_permlane32_swap_b32 v11, v23
    v_add_f32 v8, v8, v20
    v_add_f32 v9, v9, v21
    v_add_f32 v10, v10, v22
    v_add_f32 v11, v11, v23
    s_mov_b64 exec, 0xff
    ds_write_b128 v209, v[8:11]
    s_mov_b64 exec, 1
    ds_write_b32 v210, v17 offset:128
    s_mov_b64 exec, -1
    s_waitcnt vmcnt(4)
    v_perm_b32 v96, v68, v64, s66
    v_perm_b32 v97, v76, v72, s66
    v_perm_b32 v98, v84, v80, s66
    v_perm_b32 v99, v92, v88, s66
    v_perm_b32 v100, v68, v64, s67
    v_perm_b32 v101, v76, v72, s67
    v_perm_b32 v102, v84, v80, s67
    v_perm_b32 v103, v92, v88, s67
    v_perm_b32 v104, v69, v65, s66
    v_perm_b32 v105, v77, v73, s66
    v_perm_b32 v106, v85, v81, s66
    v_perm_b32 v107, v93, v89, s66
    v_perm_b32 v108, v69, v65, s67
    v_perm_b32 v109, v77, v73, s67
    v_perm_b32 v110, v85, v81, s67
    v_perm_b32 v111, v93, v89, s67
    v_perm_b32 v112, v70, v66, s66
    v_perm_b32 v113, v78, v74, s66
    v_perm_b32 v114, v86, v82, s66
    v_perm_b32 v115, v94, v90, s66
    v_perm_b32 v116, v70, v66, s67
    v_perm_b32 v117, v78, v74, s67
    v_perm_b32 v118, v86, v82, s67
    v_perm_b32 v119, v94, v90, s67
    v_perm_b32 v120, v71, v67, s66
    v_perm_b32 v121, v79, v75, s66
    v_perm_b32 v122, v87, v83, s66
    v_perm_b32 v123, v95, v91, s66
    v_perm_b32 v124, v71, v67, s67
    v_perm_b32 v125, v79, v75, s67
    v_perm_b32 v126, v87, v83, s67
    v_perm_b32 v127, v95, v91, s67
    s_waitcnt lgkmcnt(0)
    s_barrier
    ds_read_b32 v24, v212 offset:53888
    ds_read_b128 v[8:11], v211 offset:53760
    ds_read_b128 v[16:19], v211 offset:53904
    ds_read_b128 v[12:15], v211 offset:53776
    ds_read_b128 v[20:23], v211 offset:53920
    s_waitcnt lgkmcnt(4)
    v_rcp_f32 v24, v24
    s_waitcnt lgkmcnt(2)
    v_add_f32 v8, v8, v16
    v_add_f32 v9, v9, v17
    v_add_f32 v10, v10, v18
    v_add_f32 v11, v11, v19
    v_mul_f32 v8, v24, v8
    v_mul_f32 v9, v24, v9
    v_mul_f32 v10, v24, v10
    v_mul_f32 v11, v24, v11
    s_waitcnt lgkmcnt(0)
    v_add_f32 v12, v12, v20
    v_add_f32 v13, v13, v21
    v_add_f32 v14, v14, v22
    v_add_f32 v15, v15, v23
    v_cvt_pk_bf16_f32 v176, v8, v9
    v_cvt_pk_bf16_f32 v177, v10, v11
    v_mul_f32 v12, v24, v12
    v_mul_f32 v13, v24, v13
    v_mul_f32 v14, v24, v14
    v_mul_f32 v15, v24, v15
    v_cvt_pk_bf16_f32 v178, v12, v13
    v_cvt_pk_bf16_f32 v179, v14, v15
    s_nop 1
    v_mfma_f32_16x16x32_bf16 v[32:35], v[176:179], v[96:99], 0
    v_mfma_f32_16x16x32_bf16 v[40:43], v[176:179], v[104:107], 0
    v_mfma_f32_16x16x32_bf16 v[36:39], v[176:179], v[100:103], 0
    v_mfma_f32_16x16x32_bf16 v[44:47], v[176:179], v[108:111], 0
    v_mfma_f32_16x16x32_bf16 v[48:51], v[176:179], v[112:115], 0
    v_mfma_f32_16x16x32_bf16 v[52:55], v[176:179], v[116:119], 0
    v_mfma_f32_16x16x32_bf16 v[56:59], v[176:179], v[120:123], 0
    v_mfma_f32_16x16x32_bf16 v[60:63], v[176:179], v[124:127], 0
    s_nop 1
    v_cndmask_b32 v8, v32, v40, s[16:17]
    v_cndmask_b32 v9, v33, v41, s[16:17]
    v_cndmask_b32 v10, v36, v44, s[16:17]
    v_cndmask_b32 v11, v37, v45, s[16:17]
    v_cndmask_b32 v8, v8, v48, s[18:19]
    v_cndmask_b32 v9, v9, v49, s[18:19]
    v_cndmask_b32 v10, v10, v52, s[18:19]
    v_cndmask_b32 v11, v11, v53, s[18:19]
    v_cndmask_b32 v8, v8, v56, s[20:21]
    v_cndmask_b32 v9, v9, v57, s[20:21]
    v_cndmask_b32 v10, v10, v60, s[20:21]
    v_cndmask_b32 v11, v11, v61, s[20:21]
    v_bfi_b32 v8, s90, v215, v8
    v_bfi_b32 v9, s90, v215, v9
    v_bfi_b32 v10, s90, v215, v10
    v_bfi_b32 v11, s90, v215, v11
    buffer_store_dwordx4 v[8:11], v213, s[40:43], s14 offen sc1
    s_cmp_lt_u32 s2, 64
    s_cbranch_scc0 L_fin
    s_mov_b32 s74, 65536
L_p2:
    s_waitcnt vmcnt(0)
    s_mov_b64 exec, -1
    v_xor_b32 v24, v215, v128
    v_bitop3_b32 v24, v24, v129, v215 bitop3:0xf6
    v_bitop3_b32 v24, v24, v130, v215 bitop3:0xf6
    v_bitop3_b32 v24, v24, v131, v215 bitop3:0xf6
    v_bitop3_b32 v24, v24, v132, v215 bitop3:0xf6
    v_bitop3_b32 v24, v24, v133, v215 bitop3:0xf6
    v_bitop3_b32 v24, v24, v134, v215 bitop3:0xf6
    v_bitop3_b32 v24, v24, v135, v215 bitop3:0xf6
    v_bitop3_b32 v24, v24, v136, v215 bitop3:0xf6
    v_bitop3_b32 v24, v24, v137, v215 bitop3:0xf6
    v_bitop3_b32 v24, v24, v138, v215 bitop3:0xf6
    v_bitop3_b32 v24, v24, v139, v215 bitop3:0xf6
    v_bitop3_b32 v24, v24, v140, v215 bitop3:0xf6
    v_bitop3_b32 v24, v24, v141, v215 bitop3:0xf6
    v_bitop3_b32 v24, v24, v142, v215 bitop3:0xf6
    v_bitop3_b32 v24, v24, v143, v215 bitop3:0xf6
    v_and_b32 v24, s90, v24
    v_cmp_ne_u32 vcc, 0, v24
    s_nop 0
    s_cbranch_vccz L_p2ok
    s_sub_u32 s74, s74, 1
    s_cbranch_scc1 L_p2ok
    s_mov_b64 exec, vcc
    buffer_load_dwordx4 v[128:131], v214, s[40:43], s15 offen offset:0 sc1
    buffer_load_dwordx4 v[132:135], v214, s[40:43], s15 offen offset:1024 sc1
    buffer_load_dwordx4 v[136:139], v214, s[40:43], s15 offen offset:2048 sc1
    buffer_load_dwordx4 v[140:143], v214, s[40:43], s15 offen offset:3072 sc1
    s_branch L_p2
L_p2ok:
    v_and_b32 v8, s91, v128
    v_and_b32 v9, s91, v129
    v_and_b32 v10, s91, v130
    v_and_b32 v11, s91, v131
    v_and_b32 v12, s91, v132
    v_and_b32 v13, s91, v133
    v_and_b32 v14, s91, v134
    v_and_b32 v15, s91, v135
    v_and_b32 v16, s91, v136
    v_and_b32 v17, s91, v137
    v_and_b32 v18, s91, v138
    v_and_b32 v19, s91, v139
    v_and_b32 v20, s91, v140
    v_and_b32 v21, s91, v141
    v_and_b32 v22, s91, v142
    v_and_b32 v23, s91, v143
    v_add_f32 v8, v8, v12
    v_add_f32 v9, v9, v13
    v_add_f32 v10, v10, v14
    v_add_f32 v11, v11, v15
    v_add_f32 v16, v16, v20
    v_add_f32 v17, v17, v21
    v_add_f32 v18, v18, v22
    v_add_f32 v19, v19, v23
    v_add_f32 v8, v8, v16
    v_add_f32 v9, v9, v17
    v_add_f32 v10, v10, v18
    v_add_f32 v11, v11, v19
    v_add_f32_dpp v8, v8, v8 row_ror:8 row_mask:0xf bank_mask:0xf
    v_add_f32_dpp v9, v9, v9 row_ror:8 row_mask:0xf bank_mask:0xf
    v_add_f32_dpp v10, v10, v10 row_ror:8 row_mask:0xf bank_mask:0xf
    v_add_f32_dpp v11, v11, v11 row_ror:8 row_mask:0xf bank_mask:0xf
    v_mov_b32 v20, v8
    v_mov_b32 v21, v9
    v_mov_b32 v22, v10
    v_mov_b32 v23, v11
    v_permlane16_swap_b32 v8, v20
    v_permlane16_swap_b32 v9, v21
    v_permlane16_swap_b32 v10, v22
    v_permlane16_swap_b32 v11, v23
    v_add_f32 v8, v8, v20
    v_add_f32 v9, v9, v21
    v_add_f32 v10, v10, v22
    v_add_f32 v11, v11, v23
    v_mov_b32 v20, v8
    v_mov_b32 v21, v9
    v_mov_b32 v22, v10
    v_mov_b32 v23, v11
    v_permlane32_swap_b32 v8, v20
    v_permlane32_swap_b32 v9, v21
    v_permlane32_swap_b32 v10, v22
    v_permlane32_swap_b32 v11, v23
    v_add_f32 v8, v8, v20
    v_add_f32 v9, v9, v21
    v_add_f32 v10, v10, v22
    v_add_f32 v11, v11, v23
    s_mov_b64 exec, 0xff
    ds_write_b128 v217, v[8:11]
    s_waitcnt lgkmcnt(0)
    s_barrier
    s_cmp_eq_u32 s3, 0
    s_cbranch_scc0 L_fin
    ds_read_b128 v[8:11], v218 offset:0
    ds_read_b128 v[12:15], v218 offset:128
    ds_read_b128 v[16:19], v218 offset:256
    ds_read_b128 v[20:23], v218 offset:384
    s_waitcnt lgkmcnt(2)
    v_add_f32 v8, v8, v12
    v_add_f32 v9, v9, v13
    v_add_f32 v10, v10, v14
    v_add_f32 v11, v11, v15
    s_waitcnt lgkmcnt(0)
    v_add_f32 v16, v16, v20
    v_add_f32 v17, v17, v21
    v_add_f32 v18, v18, v22
    v_add_f32 v19, v19, v23
    v_add_f32 v8, v8, v16
    v_add_f32 v9, v9, v17
    v_add_f32 v10, v10, v18
    v_add_f32 v11, v11, v19
    v_cvt_pk_bf16_f32 v8, v8, v10
    v_cvt_pk_bf16_f32 v9, v9, v11
    buffer_store_dword v8, v216, s[48:51], s22 offen
    buffer_store_dword v9, v216, s[48:51], s22 offen offset:2048
    s_cmp_eq_u32 s2, 0
    s_cbranch_scc0 L_noep
    s_mov_b64 exec, 1
    v_mov_b32 v12, s64
    buffer_store_dword v12, off, s[40:43], 0 sc1
L_noep:
L_fin:
    s_mov_b64 exec, -1
L_end:
    s_endpgm
.section .rodata,"a"
.p2align 6
.amdhsa_kernel concat_heads__gqa_block_cached__sliding_block_cached__decode_kernel
  .amdhsa_next_free_vgpr 340
  .amdhsa_next_free_sgpr 102
  .amdhsa_accum_offset 228
  .amdhsa_group_segment_fixed_size 0
  .amdhsa_kernarg_size 104
  .amdhsa_user_sgpr_count 2
  .amdhsa_user_sgpr_kernarg_segment_ptr 1
  .amdhsa_system_sgpr_workgroup_id_x 1
.end_amdhsa_kernel
```
